```python
import torch

def _softmax(x, axis=-1):
    return torch.softmax(x, dim=axis)
def _gelu(x):
    return torch.nn.functional.gelu(x, approximate="tanh")
def _silu(x):
    return torch.nn.functional.silu(x)
def _sigmoid(x):
    return torch.sigmoid(x)
def _layernorm(x, axis=-1, eps=1e-5):
    m = x.mean(dim=axis, keepdim=True)
    v = x.var(dim=axis, keepdim=True, unbiased=False)
    return (x - m) / torch.sqrt(v + eps)
def _scatter_add(tgt, idx, src, axis=0):
    return tgt.clone().index_add_(axis, idx, src)
def _segment_sum(src, seg, n):
    out = torch.zeros((n,) + src.shape[1:], dtype=src.dtype)
    return out.index_add_(0, seg, src)
def _pad(x, pw):
    flat = tuple(v for pair in reversed(pw) for v in pair)
    return torch.nn.functional.pad(x, flat)

kernel_name = 'standalone__sliding_local_strided__prompt'

def setup_inputs():

    _w = (lambda a: (lambda t: t.to(torch.bfloat16) if t.is_floating_point() else t)(torch.as_tensor(a)))
    B, H, S, D = 1, 32, 2048, 128
    return {
        "q": _w((lambda *s: torch.randn(*s, dtype=torch.bfloat16) * 0.8)(B, H, S, D)),
        "k": _w((lambda *s: torch.randn(*s, dtype=torch.bfloat16) * 0.8)(B, H, S, D)),
        "v": _w((lambda *s: torch.randn(*s, dtype=torch.bfloat16) * 0.05)(B, H, S, D)),
    }

def reference(q, k, v):
    B, H, S, D = q.shape
    W, dil = 8, 4
    scale = D ** -0.5
    pos = torch.arange(S)
    kidx = pos[:, None] - torch.arange(W)[None, :] * dil
    valid = kidx >= 0
    kidx = torch.where(valid, kidx, torch.zeros_like(kidx))
    idx = torch.reshape(kidx, (1, 1, S * W, 1))
    idx = (lambda x, n, axis: torch.repeat_interleave(x, n, dim=axis))(idx, B, 0)
    idx = (lambda x, n, axis: torch.repeat_interleave(x, n, dim=axis))(idx, H, 1)
    idx = (lambda x, n, axis: torch.repeat_interleave(x, n, dim=axis))(idx, D, 3)
    kg = torch.reshape((lambda x, i, axis: torch.take_along_dim(x, i, dim=axis))(k, idx, 2), (B, H, S, W, D))
    vg = torch.reshape((lambda x, i, axis: torch.take_along_dim(x, i, dim=axis))(v, idx, 2), (B, H, S, W, D))
    scores = torch.einsum("bhsd,bhswd->bhsw", q, kg) * scale
    mask_f = (lambda x, dt: x.to(dt))(valid, q.dtype)[None, None, :, :]
    scores = scores + (mask_f - 1.0) * 1e9
    p = _softmax(scores, axis=-1)
    return torch.einsum("bhsw,bhswd->bhsd", p, vg)
```

```asm
; @launch grid=(256,1,1) block=(256,1,1) lds=147456
.amdgcn_target "amdgcn-amd-amdhsa--gfx950"
.text
.globl standalone__sliding_local_strided__prompt_kernel
.p2align 8
.type standalone__sliding_local_strided__prompt_kernel,@function
standalone__sliding_local_strided__prompt_kernel:
  s_load_dwordx2 s[16:17], s[0:1], 8
  s_load_dwordx2 s[12:13], s[0:1], 0
  s_load_dwordx2 s[20:21], s[0:1], 16
  s_load_dwordx2 s[24:25], s[0:1], 24
  s_cmp_ge_u32 s2, 256
  s_cbranch_scc1 L_end
  s_and_b32 s3, s2, 7
  s_lshl_b32 s3, s3, 21
  s_lshr_b32 s4, s2, 6
  s_lshl_b32 s4, s4, 19
  s_add_u32 s3, s3, s4
  s_bfe_u32 s2, s2, 0x30003
  s_lshl_b32 s4, s2, 16
  s_add_u32 s28, s3, s4
  s_cmp_eq_u32 s2, 0
  s_cselect_b32 s5, 0x40000000, 0
  s_cselect_b64 s[40:41], -1, 0
  v_and_b32 v15, 15, v0
  v_bfe_u32 v16, v0, 4, 2
  v_lshrrev_b32 v17, 6, v0
  v_lshlrev_b32 v18, 8, v17
  v_lshl_add_u32 v18, v16, 12, v18
  v_readfirstlane_b32 s6, v17
  v_lshl_add_u32 v5, v15, 4, v18
  v_lshlrev_b32 v19, 6, v16
  v_xor_b32 v1, v5, v19
  s_mul_i32 s6, s6, 36864
  v_xor_b32 v2, 16, v1
  v_xor_b32 v3, 32, v1
  v_xor_b32 v4, 48, v1
  s_mov_b32 s18, 0x1000000
  s_mov_b32 s19, 0x20000
  s_mov_b32 s14, 0x1000000
  s_mov_b32 s15, 0x20000
  s_mov_b32 s22, 0x1000000
  s_mov_b32 s23, 0x20000
  s_mov_b32 s26, 0x1000000
  s_mov_b32 s27, 0x20000
  s_add_u32 s29, s28, 16384
  s_add_u32 s30, s28, 32768
  s_add_u32 s31, s28, 49152
  s_sub_u32 s7, s28, 0x4000
  s_max_i32 s7, s7, 0
  v_cmp_gt_u32 vcc, 2, v16
  v_mov_b32 v19, s5
  v_mov_b32 v18, 0x40000000
  v_cndmask_b32 v19, v19, v18, vcc
  v_or_b32 v6, v1, v19
  v_or_b32 v7, v2, v19
  v_or_b32 v8, v3, v19
  v_or_b32 v9, v4, v19
  v_or_b32 v10, v5, v19
  s_waitcnt lgkmcnt(0)
  s_add_u32 m0, s6, 4096
  s_nop 0
  buffer_load_dwordx4 v1, s[16:19], s28 offen offset:0 nt lds
  buffer_load_dwordx4 v2, s[16:19], s28 offen offset:1024 nt lds
  buffer_load_dwordx4 v3, s[16:19], s28 offen offset:2048 nt lds
  buffer_load_dwordx4 v4, s[16:19], s28 offen offset:3072 nt lds
  s_add_u32 m0, s6, 0
  s_nop 0
  buffer_load_dwordx4 v6, s[16:19], s7 offen offset:0  lds
  buffer_load_dwordx4 v7, s[16:19], s7 offen offset:1024  lds
  buffer_load_dwordx4 v8, s[16:19], s7 offen offset:2048  lds
  buffer_load_dwordx4 v9, s[16:19], s7 offen offset:3072  lds
  s_add_u32 m0, s6, 20480
  s_nop 0
  buffer_load_dwordx4 v1, s[12:15], s28 offen offset:0 nt lds
  buffer_load_dwordx4 v2, s[12:15], s28 offen offset:1024 nt lds
  buffer_load_dwordx4 v3, s[12:15], s28 offen offset:2048 nt lds
  buffer_load_dwordx4 v4, s[12:15], s28 offen offset:3072 nt lds
  s_add_u32 m0, s6, 24576
  s_nop 0
  buffer_load_dwordx4 v1, s[12:15], s29 offen offset:0 nt lds
  buffer_load_dwordx4 v2, s[12:15], s29 offen offset:1024 nt lds
  buffer_load_dwordx4 v3, s[12:15], s29 offen offset:2048 nt lds
  buffer_load_dwordx4 v4, s[12:15], s29 offen offset:3072 nt lds
  v_and_b32 v18, 3, v15
  v_lshlrev_b32 v18, 10, v18
  v_lshrrev_b32 v19, 2, v15
  v_lshl_add_u32 v18, v19, 8, v18
  v_xor_b32 v19, v16, v15
  v_lshl_add_u32 v18, v19, 4, v18
  v_add_u32 v11, s6, v18
  v_xor_b32 v12, 64, v11
  v_xor_b32 v13, 128, v11
  v_xor_b32 v14, 192, v11
  v_lshlrev_b32 v16, 2, v16
  v_sub_u32 v16, v16, v15
  v_mov_b32 v18, 0xf149f2ca
  v_add_u32 v19, 7, v16
  v_cmp_ge_u32 vcc, 7, v19
  v_cmp_le_i32 s[42:43], 16, v19
  s_nop 0
  v_cndmask_b32 v24, v18, 0, vcc
  v_cndmask_b32 v20, v18, 0, s[42:43]
  v_cndmask_b32 v28, v20, v18, s[40:41]
  v_add_u32 v19, 8, v16
  v_cmp_ge_u32 vcc, 7, v19
  v_cmp_le_i32 s[42:43], 16, v19
  s_nop 0
  v_cndmask_b32 v25, v18, 0, vcc
  v_cndmask_b32 v21, v18, 0, s[42:43]
  v_cndmask_b32 v29, v21, v18, s[40:41]
  v_add_u32 v19, 9, v16
  v_cmp_ge_u32 vcc, 7, v19
  v_cmp_le_i32 s[42:43], 16, v19
  s_nop 0
  v_cndmask_b32 v26, v18, 0, vcc
  v_cndmask_b32 v22, v18, 0, s[42:43]
  v_cndmask_b32 v30, v22, v18, s[40:41]
  v_add_u32 v19, 10, v16
  v_cmp_ge_u32 vcc, 7, v19
  v_cmp_le_i32 s[42:43], 16, v19
  s_nop 0
  v_cndmask_b32 v27, v18, 0, vcc
  v_cndmask_b32 v23, v18, 0, s[42:43]
  v_cndmask_b32 v31, v23, v18, s[40:41]
  v_mov_b32 v15, 0xffff
  v_mov_b32 v17, 0xffff0000
  v_cmp_lt_i32 vcc, 0, v16
  v_cmp_lt_i32 s[42:43], -1, v16
  s_nop 1
  v_cndmask_b32 v19, 0, v15, vcc
  v_cndmask_b32 v32, 0, v17, s[42:43]
  v_or_b32 v32, v32, v19
  v_cmp_lt_i32 vcc, -2, v16
  v_cmp_lt_i32 s[42:43], -3, v16
  s_nop 1
  v_cndmask_b32 v19, 0, v15, vcc
  v_cndmask_b32 v33, 0, v17, s[42:43]
  v_or_b32 v33, v33, v19
  s_mov_b32 s44, 0x05040100
  s_mov_b32 s45, 0x07060302
  s_mov_b32 s46, 0x3fb8aa3b
  s_mov_b32 s47, 0x3db504f3
  s_waitcnt vmcnt(12)
  s_waitcnt vmcnt(8)
  s_add_u32 m0, s6, 8192
  s_nop 0
  buffer_load_dwordx4 v1, s[16:19], s29 offen offset:0 nt lds
  buffer_load_dwordx4 v2, s[16:19], s29 offen offset:1024 nt lds
  buffer_load_dwordx4 v3, s[16:19], s29 offen offset:2048 nt lds
  buffer_load_dwordx4 v4, s[16:19], s29 offen offset:3072 nt lds
  s_waitcnt vmcnt(8)
  ds_read_b128 a[0:3], v11 offset:0
  ds_read_b128 a[4:7], v12 offset:0
  ds_read_b128 a[8:11], v13 offset:0
  ds_read_b128 a[12:15], v14 offset:0
  ds_read_b128 a[32:35], v11 offset:20480
  ds_read_b128 a[16:19], v11 offset:4096
  ds_read_b128 a[36:39], v12 offset:20480
  ds_read_b128 a[20:23], v12 offset:4096
  ds_read_b128 a[40:43], v13 offset:20480
  ds_read_b128 a[24:27], v13 offset:4096
  ds_read_b128 a[44:47], v14 offset:20480
  ds_read_b128 a[28:31], v14 offset:4096
  s_add_u32 m0, s6, 28672
  s_nop 0
  buffer_load_dwordx4 v1, s[12:15], s30 offen offset:0 nt lds
  buffer_load_dwordx4 v2, s[12:15], s30 offen offset:1024 nt lds
  buffer_load_dwordx4 v3, s[12:15], s30 offen offset:2048 nt lds
  buffer_load_dwordx4 v4, s[12:15], s30 offen offset:3072 nt lds
  s_waitcnt lgkmcnt(7)
  v_mfma_f32_16x16x32_bf16 v[36:39], a[0:3], a[32:35], v[28:31]
  s_waitcnt lgkmcnt(6)
  v_mfma_f32_16x16x32_bf16 v[40:43], a[16:19], a[32:35], v[24:27]
  s_waitcnt lgkmcnt(5)
  v_mfma_f32_16x16x32_bf16 v[36:39], a[4:7], a[36:39], v[36:39]
  s_waitcnt lgkmcnt(4)
  v_mfma_f32_16x16x32_bf16 v[40:43], a[20:23], a[36:39], v[40:43]
  s_waitcnt lgkmcnt(3)
  v_mfma_f32_16x16x32_bf16 v[36:39], a[8:11], a[40:43], v[36:39]
  s_waitcnt lgkmcnt(2)
  v_mfma_f32_16x16x32_bf16 v[40:43], a[24:27], a[40:43], v[40:43]
  s_waitcnt lgkmcnt(1)
  v_mfma_f32_16x16x32_bf16 v[36:39], a[12:15], a[44:47], v[36:39]
  s_waitcnt lgkmcnt(0)
  v_mfma_f32_16x16x32_bf16 v[40:43], a[28:31], a[44:47], v[40:43]
  s_nop 7
  v_max_f32 v36, v36, v40
  v_max_f32 v37, v37, v41
  v_max_f32 v38, v38, v42
  v_max_f32 v39, v39, v43
  v_cvt_pk_bf16_f32 v40, v36, v37
  v_cvt_pk_bf16_f32 v41, v38, v39
  v_lshlrev_b32 v36, 16, v40
  v_and_b32 v37, 0xffff0000, v40
  v_lshlrev_b32 v38, 16, v41
  v_and_b32 v39, 0xffff0000, v41
  v_mul_f32 v36, s47, v36
  v_mul_f32 v37, s47, v37
  v_mul_f32 v38, s47, v38
  v_mul_f32 v39, s47, v39
  v_cvt_pk_bf16_f32 v40, v36, v37
  v_cvt_pk_bf16_f32 v41, v38, v39
  v_lshlrev_b32 v36, 16, v40
  v_and_b32 v37, 0xffff0000, v40
  v_lshlrev_b32 v38, 16, v41
  v_and_b32 v39, 0xffff0000, v41
  v_max3_f32 v34, v36, v37, v38
  v_max_f32 v34, v34, v39
  v_mov_b32 v35, v34
  s_nop 1
  v_permlane32_swap_b32 v34, v35
  v_max_f32 v34, v34, v35
  v_mov_b32 v35, v34
  s_nop 1
  v_permlane16_swap_b32 v34, v35
  v_max_f32 v34, v34, v35
  v_mul_f32 v34, s46, v34
  v_fma_f32 v36, v36, s46, -v34
  v_fma_f32 v37, v37, s46, -v34
  v_fma_f32 v38, v38, s46, -v34
  v_fma_f32 v39, v39, s46, -v34
  v_exp_f32 v36, v36
  v_exp_f32 v37, v37
  v_exp_f32 v38, v38
  v_exp_f32 v39, v39
  v_add_f32 v34, v36, v37
  v_add_f32 v35, v38, v39
  v_add_f32 v34, v34, v35
  v_mov_b32 v35, v34
  s_nop 1
  v_permlane32_swap_b32 v34, v35
  v_add_f32 v34, v34, v35
  v_mov_b32 v35, v34
  s_nop 1
  v_permlane16_swap_b32 v34, v35
  v_add_f32 v34, v34, v35
  v_rcp_f32 v34, v34
  s_nop 0
  v_mul_f32 v36, v36, v34
  v_mul_f32 v37, v37, v34
  v_mul_f32 v38, v38, v34
  v_mul_f32 v39, v39, v34
  v_cvt_pk_bf16_f32 v40, v36, v37
  v_cvt_pk_bf16_f32 v41, v38, v39
  v_and_b32 v44, v40, v32
  v_and_b32 v45, v41, v33
  v_bfi_b32 v46, v32, 0, v40
  v_bfi_b32 v47, v33, 0, v41
  s_waitcnt vmcnt(8)
  s_add_u32 m0, s6, 12288
  s_nop 0
  buffer_load_dwordx4 v1, s[16:19], s30 offen offset:0 nt lds
  buffer_load_dwordx4 v2, s[16:19], s30 offen offset:1024 nt lds
  buffer_load_dwordx4 v3, s[16:19], s30 offen offset:2048 nt lds
  buffer_load_dwordx4 v4, s[16:19], s30 offen offset:3072 nt lds
  s_waitcnt vmcnt(8)
  ds_read_b128 a[32:35], v11 offset:24576
  ds_read_b128 a[0:3], v11 offset:8192
  ds_read_b128 a[36:39], v12 offset:24576
  ds_read_b128 a[4:7], v12 offset:8192
  ds_read_b128 a[40:43], v13 offset:24576
  ds_read_b128 a[8:11], v13 offset:8192
  ds_read_b128 a[44:47], v14 offset:24576
  ds_read_b128 a[12:15], v14 offset:8192
  buffer_load_dwordx4 v[188:191], v10, s[20:23], s7 offen offset:0
  buffer_load_dwordx4 v[192:195], v10, s[20:23], s7 offen offset:1024
  buffer_load_dwordx4 v[196:199], v10, s[20:23], s7 offen offset:2048
  buffer_load_dwordx4 v[200:203], v10, s[20:23], s7 offen offset:3072
  s_waitcnt lgkmcnt(7)
  v_mfma_f32_16x16x32_bf16 v[36:39], a[16:19], a[32:35], v[20:23]
  s_waitcnt lgkmcnt(6)
  v_mfma_f32_16x16x32_bf16 v[40:43], a[0:3], a[32:35], v[24:27]
  s_waitcnt lgkmcnt(5)
  v_mfma_f32_16x16x32_bf16 v[36:39], a[20:23], a[36:39], v[36:39]
  s_waitcnt lgkmcnt(4)
  v_mfma_f32_16x16x32_bf16 v[40:43], a[4:7], a[36:39], v[40:43]
  s_waitcnt lgkmcnt(3)
  v_mfma_f32_16x16x32_bf16 v[36:39], a[24:27], a[40:43], v[36:39]
  s_waitcnt lgkmcnt(2)
  v_mfma_f32_16x16x32_bf16 v[40:43], a[8:11], a[40:43], v[40:43]
  s_waitcnt lgkmcnt(1)
  v_mfma_f32_16x16x32_bf16 v[36:39], a[28:31], a[44:47], v[36:39]
  s_waitcnt lgkmcnt(0)
  v_mfma_f32_16x16x32_bf16 v[40:43], a[12:15], a[44:47], v[40:43]
  s_nop 7
  v_max_f32 v36, v36, v40
  v_max_f32 v37, v37, v41
  v_max_f32 v38, v38, v42
  v_max_f32 v39, v39, v43
  v_cvt_pk_bf16_f32 v40, v36, v37
  v_cvt_pk_bf16_f32 v41, v38, v39
  v_lshlrev_b32 v36, 16, v40
  v_and_b32 v37, 0xffff0000, v40
  v_lshlrev_b32 v38, 16, v41
  v_and_b32 v39, 0xffff0000, v41
  v_mul_f32 v36, s47, v36
  v_mul_f32 v37, s47, v37
  v_mul_f32 v38, s47, v38
  v_mul_f32 v39, s47, v39
  v_cvt_pk_bf16_f32 v40, v36, v37
  v_cvt_pk_bf16_f32 v41, v38, v39
  v_lshlrev_b32 v36, 16, v40
  v_and_b32 v37, 0xffff0000, v40
  v_lshlrev_b32 v38, 16, v41
  v_and_b32 v39, 0xffff0000, v41
  v_max3_f32 v34, v36, v37, v38
  v_max_f32 v34, v34, v39
  v_mov_b32 v35, v34
  s_nop 1
  v_permlane32_swap_b32 v34, v35
  v_max_f32 v34, v34, v35
  v_mov_b32 v35, v34
  s_nop 1
  v_permlane16_swap_b32 v34, v35
  v_max_f32 v34, v34, v35
  v_mul_f32 v34, s46, v34
  v_fma_f32 v36, v36, s46, -v34
  v_fma_f32 v37, v37, s46, -v34
  v_fma_f32 v38, v38, s46, -v34
  v_fma_f32 v39, v39, s46, -v34
  v_exp_f32 v36, v36
  v_exp_f32 v37, v37
  v_exp_f32 v38, v38
  v_exp_f32 v39, v39
  v_add_f32 v34, v36, v37
  v_add_f32 v35, v38, v39
  v_add_f32 v34, v34, v35
  v_mov_b32 v35, v34
  s_nop 1
  v_permlane32_swap_b32 v34, v35
  v_add_f32 v34, v34, v35
  v_mov_b32 v35, v34
  s_nop 1
  v_permlane16_swap_b32 v34, v35
  v_add_f32 v34, v34, v35
  v_rcp_f32 v34, v34
  s_nop 0
  v_mul_f32 v36, v36, v34
  v_mul_f32 v37, v37, v34
  v_mul_f32 v38, v38, v34
  v_mul_f32 v39, v39, v34
  v_cvt_pk_bf16_f32 v40, v36, v37
  v_cvt_pk_bf16_f32 v41, v38, v39
  v_and_b32 v50, v40, v32
  v_and_b32 v51, v41, v33
  v_bfi_b32 v48, v32, 0, v40
  v_bfi_b32 v49, v33, 0, v41
  s_waitcnt vmcnt(8)
  buffer_load_dwordx4 v[204:207], v5, s[20:23], s28 offen offset:0 nt
  buffer_load_dwordx4 v[208:211], v5, s[20:23], s28 offen offset:1024 nt
  buffer_load_dwordx4 v[212:215], v5, s[20:23], s28 offen offset:2048 nt
  buffer_load_dwordx4 v[216:219], v5, s[20:23], s28 offen offset:3072 nt
  s_waitcnt vmcnt(8)
  ds_read_b128 a[32:35], v11 offset:28672
  ds_read_b128 a[16:19], v11 offset:12288
  ds_read_b128 a[36:39], v12 offset:28672
  ds_read_b128 a[20:23], v12 offset:12288
  ds_read_b128 a[40:43], v13 offset:28672
  ds_read_b128 a[24:27], v13 offset:12288
  ds_read_b128 a[44:47], v14 offset:28672
  ds_read_b128 a[28:31], v14 offset:12288
  s_add_u32 m0, s6, 32768
  s_nop 0
  buffer_load_dwordx4 v1, s[12:15], s31 offen offset:0 nt lds
  buffer_load_dwordx4 v2, s[12:15], s31 offen offset:1024 nt lds
  buffer_load_dwordx4 v3, s[12:15], s31 offen offset:2048 nt lds
  buffer_load_dwordx4 v4, s[12:15], s31 offen offset:3072 nt lds
  s_waitcnt lgkmcnt(7)
  v_mfma_f32_16x16x32_bf16 v[36:39], a[0:3], a[32:35], v[20:23]
  s_waitcnt lgkmcnt(6)
  v_mfma_f32_16x16x32_bf16 v[40:43], a[16:19], a[32:35], v[24:27]
  s_waitcnt lgkmcnt(5)
  v_mfma_f32_16x16x32_bf16 v[36:39], a[4:7], a[36:39], v[36:39]
  s_waitcnt lgkmcnt(4)
  v_mfma_f32_16x16x32_bf16 v[40:43], a[20:23], a[36:39], v[40:43]
  s_waitcnt lgkmcnt(3)
  v_mfma_f32_16x16x32_bf16 v[36:39], a[8:11], a[40:43], v[36:39]
  s_waitcnt lgkmcnt(2)
  v_mfma_f32_16x16x32_bf16 v[40:43], a[24:27], a[40:43], v[40:43]
  s_waitcnt lgkmcnt(1)
  v_mfma_f32_16x16x32_bf16 v[36:39], a[12:15], a[44:47], v[36:39]
  s_waitcnt lgkmcnt(0)
  v_mfma_f32_16x16x32_bf16 v[40:43], a[28:31], a[44:47], v[40:43]
  s_nop 7
  v_max_f32 v36, v36, v40
  v_max_f32 v37, v37, v41
  v_max_f32 v38, v38, v42
  v_max_f32 v39, v39, v43
  v_cvt_pk_bf16_f32 v40, v36, v37
  v_cvt_pk_bf16_f32 v41, v38, v39
  v_lshlrev_b32 v36, 16, v40
  v_and_b32 v37, 0xffff0000, v40
  v_lshlrev_b32 v38, 16, v41
  v_and_b32 v39, 0xffff0000, v41
  v_mul_f32 v36, s47, v36
  v_mul_f32 v37, s47, v37
  v_mul_f32 v38, s47, v38
  v_mul_f32 v39, s47, v39
  v_cvt_pk_bf16_f32 v40, v36, v37
  v_cvt_pk_bf16_f32 v41, v38, v39
  v_lshlrev_b32 v36, 16, v40
  v_and_b32 v37, 0xffff0000, v40
  v_lshlrev_b32 v38, 16, v41
  v_and_b32 v39, 0xffff0000, v41
  v_max3_f32 v34, v36, v37, v38
  v_max_f32 v34, v34, v39
  v_mov_b32 v35, v34
  s_nop 1
  v_permlane32_swap_b32 v34, v35
  v_max_f32 v34, v34, v35
  v_mov_b32 v35, v34
  s_nop 1
  v_permlane16_swap_b32 v34, v35
  v_max_f32 v34, v34, v35
  v_mul_f32 v34, s46, v34
  v_fma_f32 v36, v36, s46, -v34
  v_fma_f32 v37, v37, s46, -v34
  v_fma_f32 v38, v38, s46, -v34
  v_fma_f32 v39, v39, s46, -v34
  v_exp_f32 v36, v36
  v_exp_f32 v37, v37
  v_exp_f32 v38, v38
  v_exp_f32 v39, v39
  v_add_f32 v34, v36, v37
  v_add_f32 v35, v38, v39
  v_add_f32 v34, v34, v35
  v_mov_b32 v35, v34
  s_nop 1
  v_permlane32_swap_b32 v34, v35
  v_add_f32 v34, v34, v35
  v_mov_b32 v35, v34
  s_nop 1
  v_permlane16_swap_b32 v34, v35
  v_add_f32 v34, v34, v35
  v_rcp_f32 v34, v34
  s_nop 0
  v_mul_f32 v36, v36, v34
  v_mul_f32 v37, v37, v34
  v_mul_f32 v38, v38, v34
  v_mul_f32 v39, v39, v34
  v_cvt_pk_bf16_f32 v40, v36, v37
  v_cvt_pk_bf16_f32 v41, v38, v39
  v_and_b32 v52, v40, v32
  v_and_b32 v53, v41, v33
  v_bfi_b32 v54, v32, 0, v40
  v_bfi_b32 v55, v33, 0, v41
  s_waitcnt vmcnt(8)
  s_add_u32 m0, s6, 16384
  s_nop 0
  buffer_load_dwordx4 v1, s[16:19], s31 offen offset:0 nt lds
  buffer_load_dwordx4 v2, s[16:19], s31 offen offset:1024 nt lds
  buffer_load_dwordx4 v3, s[16:19], s31 offen offset:2048 nt lds
  buffer_load_dwordx4 v4, s[16:19], s31 offen offset:3072 nt lds
  v_perm_b32 v60, v192, v188, s44
  v_perm_b32 v61, v200, v196, s44
  v_perm_b32 v64, v192, v188, s45
  v_perm_b32 v65, v200, v196, s45
  v_perm_b32 v68, v193, v189, s44
  v_perm_b32 v69, v201, v197, s44
  v_perm_b32 v72, v193, v189, s45
  v_perm_b32 v73, v201, v197, s45
  v_perm_b32 v76, v194, v190, s44
  v_perm_b32 v77, v202, v198, s44
  v_perm_b32 v80, v194, v190, s45
  v_perm_b32 v81, v202, v198, s45
  v_perm_b32 v84, v195, v191, s44
  v_perm_b32 v85, v203, v199, s44
  v_perm_b32 v88, v195, v191, s45
  v_perm_b32 v89, v203, v199, s45
  s_waitcnt vmcnt(8)
  buffer_load_dwordx4 v[220:223], v5, s[20:23], s29 offen offset:0 nt
  buffer_load_dwordx4 v[224:227], v5, s[20:23], s29 offen offset:1024 nt
  buffer_load_dwordx4 v[228:231], v5, s[20:23], s29 offen offset:2048 nt
  buffer_load_dwordx4 v[232:235], v5, s[20:23], s29 offen offset:3072 nt
  v_perm_b32 v62, v208, v204, s44
  v_perm_b32 v63, v216, v212, s44
  v_perm_b32 v66, v208, v204, s45
  v_perm_b32 v67, v216, v212, s45
  v_mfma_f32_16x16x32_bf16 v[92:95], v[44:47], v[60:63], 0
  v_perm_b32 v70, v209, v205, s44
  v_perm_b32 v71, v217, v213, s44
  v_mfma_f32_16x16x32_bf16 v[96:99], v[44:47], v[64:67], 0
  v_perm_b32 v74, v209, v205, s45
  v_perm_b32 v75, v217, v213, s45
  v_mfma_f32_16x16x32_bf16 v[100:103], v[44:47], v[68:71], 0
  v_perm_b32 v78, v210, v206, s44
  v_perm_b32 v79, v218, v214, s44
  v_mfma_f32_16x16x32_bf16 v[104:107], v[44:47], v[72:75], 0
  v_perm_b32 v82, v210, v206, s45
  v_perm_b32 v83, v218, v214, s45
  v_mfma_f32_16x16x32_bf16 v[108:111], v[44:47], v[76:79], 0
  v_perm_b32 v86, v211, v207, s44
  v_perm_b32 v87, v219, v215, s44
  v_mfma_f32_16x16x32_bf16 v[112:115], v[44:47], v[80:83], 0
  v_perm_b32 v90, v211, v207, s45
  v_perm_b32 v91, v219, v215, s45
  v_mfma_f32_16x16x32_bf16 v[116:119], v[44:47], v[84:87], 0
  s_nop 0
  v_mfma_f32_16x16x32_bf16 v[120:123], v[44:47], v[88:91], 0
  v_cvt_pk_bf16_f32 v124, v92, v96
  v_cvt_pk_bf16_f32 v128, v93, v97
  v_cvt_pk_bf16_f32 v132, v94, v98
  v_cvt_pk_bf16_f32 v136, v95, v99
  v_cvt_pk_bf16_f32 v125, v100, v104
  v_cvt_pk_bf16_f32 v129, v101, v105
  v_cvt_pk_bf16_f32 v133, v102, v106
  v_cvt_pk_bf16_f32 v137, v103, v107
  v_cvt_pk_bf16_f32 v126, v108, v112
  v_cvt_pk_bf16_f32 v130, v109, v113
  v_cvt_pk_bf16_f32 v134, v110, v114
  v_cvt_pk_bf16_f32 v138, v111, v115
  v_cvt_pk_bf16_f32 v127, v116, v120
  buffer_store_dwordx4 v[124:127], v5, s[24:27], s28 offen offset:0 sc1
  v_cvt_pk_bf16_f32 v131, v117, v121
  buffer_store_dwordx4 v[128:131], v5, s[24:27], s28 offen offset:1024 sc1
  v_cvt_pk_bf16_f32 v135, v118, v122
  buffer_store_dwordx4 v[132:135], v5, s[24:27], s28 offen offset:2048 sc1
  v_cvt_pk_bf16_f32 v139, v119, v123
  buffer_store_dwordx4 v[136:139], v5, s[24:27], s28 offen offset:3072 sc1
  s_waitcnt vmcnt(12)
  buffer_load_dwordx4 v[236:239], v5, s[20:23], s30 offen offset:0 nt
  buffer_load_dwordx4 v[240:243], v5, s[20:23], s30 offen offset:1024 nt
  buffer_load_dwordx4 v[244:247], v5, s[20:23], s30 offen offset:2048 nt
  buffer_load_dwordx4 v[248:251], v5, s[20:23], s30 offen offset:3072 nt
  s_waitcnt vmcnt(12)
  ds_read_b128 a[32:35], v11 offset:32768
  ds_read_b128 a[0:3], v11 offset:16384
  ds_read_b128 a[36:39], v12 offset:32768
  ds_read_b128 a[4:7], v12 offset:16384
  ds_read_b128 a[40:43], v13 offset:32768
  ds_read_b128 a[8:11], v13 offset:16384
  ds_read_b128 a[44:47], v14 offset:32768
  ds_read_b128 a[12:15], v14 offset:16384
  buffer_load_dwordx4 v[188:191], v5, s[20:23], s31 offen offset:0 nt
  buffer_load_dwordx4 v[192:195], v5, s[20:23], s31 offen offset:1024 nt
  buffer_load_dwordx4 v[196:199], v5, s[20:23], s31 offen offset:2048 nt
  buffer_load_dwordx4 v[200:203], v5, s[20:23], s31 offen offset:3072 nt
  s_waitcnt lgkmcnt(7)
  v_mfma_f32_16x16x32_bf16 v[36:39], a[16:19], a[32:35], v[20:23]
  s_waitcnt lgkmcnt(6)
  v_mfma_f32_16x16x32_bf16 v[40:43], a[0:3], a[32:35], v[24:27]
  s_waitcnt lgkmcnt(5)
  v_mfma_f32_16x16x32_bf16 v[36:39], a[20:23], a[36:39], v[36:39]
  s_waitcnt lgkmcnt(4)
  v_mfma_f32_16x16x32_bf16 v[40:43], a[4:7], a[36:39], v[40:43]
  s_waitcnt lgkmcnt(3)
  v_mfma_f32_16x16x32_bf16 v[36:39], a[24:27], a[40:43], v[36:39]
  s_waitcnt lgkmcnt(2)
  v_mfma_f32_16x16x32_bf16 v[40:43], a[8:11], a[40:43], v[40:43]
  s_waitcnt lgkmcnt(1)
  v_mfma_f32_16x16x32_bf16 v[36:39], a[28:31], a[44:47], v[36:39]
  s_waitcnt lgkmcnt(0)
  v_mfma_f32_16x16x32_bf16 v[40:43], a[12:15], a[44:47], v[40:43]
  s_nop 7
  v_max_f32 v36, v36, v40
  v_max_f32 v37, v37, v41
  v_max_f32 v38, v38, v42
  v_max_f32 v39, v39, v43
  v_cvt_pk_bf16_f32 v40, v36, v37
  v_cvt_pk_bf16_f32 v41, v38, v39
  v_lshlrev_b32 v36, 16, v40
  v_and_b32 v37, 0xffff0000, v40
  v_lshlrev_b32 v38, 16, v41
  v_and_b32 v39, 0xffff0000, v41
  v_mul_f32 v36, s47, v36
  v_mul_f32 v37, s47, v37
  v_mul_f32 v38, s47, v38
  v_mul_f32 v39, s47, v39
  v_cvt_pk_bf16_f32 v40, v36, v37
  v_cvt_pk_bf16_f32 v41, v38, v39
  v_lshlrev_b32 v36, 16, v40
  v_and_b32 v37, 0xffff0000, v40
  v_lshlrev_b32 v38, 16, v41
  v_and_b32 v39, 0xffff0000, v41
  v_max3_f32 v34, v36, v37, v38
  v_max_f32 v34, v34, v39
  v_mov_b32 v35, v34
  s_nop 1
  v_permlane32_swap_b32 v34, v35
  v_max_f32 v34, v34, v35
  v_mov_b32 v35, v34
  s_nop 1
  v_permlane16_swap_b32 v34, v35
  v_max_f32 v34, v34, v35
  v_mul_f32 v34, s46, v34
  v_fma_f32 v36, v36, s46, -v34
  v_fma_f32 v37, v37, s46, -v34
  v_fma_f32 v38, v38, s46, -v34
  v_fma_f32 v39, v39, s46, -v34
  v_exp_f32 v36, v36
  v_exp_f32 v37, v37
  v_exp_f32 v38, v38
  v_exp_f32 v39, v39
  v_add_f32 v34, v36, v37
  v_add_f32 v35, v38, v39
  v_add_f32 v34, v34, v35
  v_mov_b32 v35, v34
  s_nop 1
  v_permlane32_swap_b32 v34, v35
  v_add_f32 v34, v34, v35
  v_mov_b32 v35, v34
  s_nop 1
  v_permlane16_swap_b32 v34, v35
  v_add_f32 v34, v34, v35
  v_rcp_f32 v34, v34
  s_nop 0
  v_mul_f32 v36, v36, v34
  v_mul_f32 v37, v37, v34
  v_mul_f32 v38, v38, v34
  v_mul_f32 v39, v39, v34
  v_cvt_pk_bf16_f32 v40, v36, v37
  v_cvt_pk_bf16_f32 v41, v38, v39
  v_and_b32 v58, v40, v32
  v_and_b32 v59, v41, v33
  v_bfi_b32 v56, v32, 0, v40
  v_bfi_b32 v57, v33, 0, v41
  s_waitcnt vmcnt(12)
  v_perm_b32 v60, v224, v220, s44
  v_perm_b32 v61, v232, v228, s44
  v_perm_b32 v64, v224, v220, s45
  v_perm_b32 v65, v232, v228, s45
  v_mfma_f32_16x16x32_bf16 v[92:95], v[48:51], v[60:63], 0
  v_perm_b32 v68, v225, v221, s44
  v_perm_b32 v69, v233, v229, s44
  v_mfma_f32_16x16x32_bf16 v[96:99], v[48:51], v[64:67], 0
  v_perm_b32 v72, v225, v221, s45
  v_perm_b32 v73, v233, v229, s45
  v_mfma_f32_16x16x32_bf16 v[100:103], v[48:51], v[68:71], 0
  v_perm_b32 v76, v226, v222, s44
  v_perm_b32 v77, v234, v230, s44
  v_mfma_f32_16x16x32_bf16 v[104:107], v[48:51], v[72:75], 0
  v_perm_b32 v80, v226, v222, s45
  v_perm_b32 v81, v234, v230, s45
  v_mfma_f32_16x16x32_bf16 v[108:111], v[48:51], v[76:79], 0
  v_perm_b32 v84, v227, v223, s44
  v_perm_b32 v85, v235, v231, s44
  v_mfma_f32_16x16x32_bf16 v[112:115], v[48:51], v[80:83], 0
  v_perm_b32 v88, v227, v223, s45
  v_perm_b32 v89, v235, v231, s45
  v_mfma_f32_16x16x32_bf16 v[116:119], v[48:51], v[84:87], 0
  s_nop 0
  v_mfma_f32_16x16x32_bf16 v[120:123], v[48:51], v[88:91], 0
  v_cvt_pk_bf16_f32 v140, v92, v96
  v_cvt_pk_bf16_f32 v144, v93, v97
  v_cvt_pk_bf16_f32 v148, v94, v98
  v_cvt_pk_bf16_f32 v152, v95, v99
  v_cvt_pk_bf16_f32 v141, v100, v104
  v_cvt_pk_bf16_f32 v145, v101, v105
  v_cvt_pk_bf16_f32 v149, v102, v106
  v_cvt_pk_bf16_f32 v153, v103, v107
  v_cvt_pk_bf16_f32 v142, v108, v112
  v_cvt_pk_bf16_f32 v146, v109, v113
  v_cvt_pk_bf16_f32 v150, v110, v114
  v_cvt_pk_bf16_f32 v154, v111, v115
  v_cvt_pk_bf16_f32 v143, v116, v120
  buffer_store_dwordx4 v[140:143], v5, s[24:27], s29 offen offset:0
  v_cvt_pk_bf16_f32 v147, v117, v121
  buffer_store_dwordx4 v[144:147], v5, s[24:27], s29 offen offset:1024
  v_cvt_pk_bf16_f32 v151, v118, v122
  buffer_store_dwordx4 v[148:151], v5, s[24:27], s29 offen offset:2048
  v_cvt_pk_bf16_f32 v155, v119, v123
  buffer_store_dwordx4 v[152:155], v5, s[24:27], s29 offen offset:3072
  s_waitcnt vmcnt(8)
  v_perm_b32 v62, v240, v236, s44
  v_perm_b32 v63, v248, v244, s44
  v_perm_b32 v66, v240, v236, s45
  v_perm_b32 v67, v248, v244, s45
  v_mfma_f32_16x16x32_bf16 v[92:95], v[52:55], v[60:63], 0
  v_perm_b32 v70, v241, v237, s44
  v_perm_b32 v71, v249, v245, s44
  v_mfma_f32_16x16x32_bf16 v[96:99], v[52:55], v[64:67], 0
  v_perm_b32 v74, v241, v237, s45
  v_perm_b32 v75, v249, v245, s45
  v_mfma_f32_16x16x32_bf16 v[100:103], v[52:55], v[68:71], 0
  v_perm_b32 v78, v242, v238, s44
  v_perm_b32 v79, v250, v246, s44
  v_mfma_f32_16x16x32_bf16 v[104:107], v[52:55], v[72:75], 0
  v_perm_b32 v82, v242, v238, s45
  v_perm_b32 v83, v250, v246, s45
  v_mfma_f32_16x16x32_bf16 v[108:111], v[52:55], v[76:79], 0
  v_perm_b32 v86, v243, v239, s44
  v_perm_b32 v87, v251, v247, s44
  v_mfma_f32_16x16x32_bf16 v[112:115], v[52:55], v[80:83], 0
  v_perm_b32 v90, v243, v239, s45
  v_perm_b32 v91, v251, v247, s45
  v_mfma_f32_16x16x32_bf16 v[116:119], v[52:55], v[84:87], 0
  s_nop 0
  v_mfma_f32_16x16x32_bf16 v[120:123], v[52:55], v[88:91], 0
  v_cvt_pk_bf16_f32 v156, v92, v96
  v_cvt_pk_bf16_f32 v160, v93, v97
  v_cvt_pk_bf16_f32 v164, v94, v98
  v_cvt_pk_bf16_f32 v168, v95, v99
  v_cvt_pk_bf16_f32 v157, v100, v104
  v_cvt_pk_bf16_f32 v161, v101, v105
  v_cvt_pk_bf16_f32 v165, v102, v106
  v_cvt_pk_bf16_f32 v169, v103, v107
  v_cvt_pk_bf16_f32 v158, v108, v112
  v_cvt_pk_bf16_f32 v162, v109, v113
  v_cvt_pk_bf16_f32 v166, v110, v114
  v_cvt_pk_bf16_f32 v170, v111, v115
  v_cvt_pk_bf16_f32 v159, v116, v120
  buffer_store_dwordx4 v[156:159], v5, s[24:27], s30 offen offset:0
  v_cvt_pk_bf16_f32 v163, v117, v121
  buffer_store_dwordx4 v[160:163], v5, s[24:27], s30 offen offset:1024
  v_cvt_pk_bf16_f32 v167, v118, v122
  buffer_store_dwordx4 v[164:167], v5, s[24:27], s30 offen offset:2048
  v_cvt_pk_bf16_f32 v171, v119, v123
  buffer_store_dwordx4 v[168:171], v5, s[24:27], s30 offen offset:3072
  s_waitcnt vmcnt(8)
  v_perm_b32 v60, v192, v188, s44
  v_perm_b32 v61, v200, v196, s44
  v_perm_b32 v64, v192, v188, s45
  v_perm_b32 v65, v200, v196, s45
  v_mfma_f32_16x16x32_bf16 v[92:95], v[56:59], v[60:63], 0
  v_perm_b32 v68, v193, v189, s44
  v_perm_b32 v69, v201, v197, s44
  v_mfma_f32_16x16x32_bf16 v[96:99], v[56:59], v[64:67], 0
  v_perm_b32 v72, v193, v189, s45
  v_perm_b32 v73, v201, v197, s45
  v_mfma_f32_16x16x32_bf16 v[100:103], v[56:59], v[68:71], 0
  v_perm_b32 v76, v194, v190, s44
  v_perm_b32 v77, v202, v198, s44
  v_mfma_f32_16x16x32_bf16 v[104:107], v[56:59], v[72:75], 0
  v_perm_b32 v80, v194, v190, s45
  v_perm_b32 v81, v202, v198, s45
  v_mfma_f32_16x16x32_bf16 v[108:111], v[56:59], v[76:79], 0
  v_perm_b32 v84, v195, v191, s44
  v_perm_b32 v85, v203, v199, s44
  v_mfma_f32_16x16x32_bf16 v[112:115], v[56:59], v[80:83], 0
  v_perm_b32 v88, v195, v191, s45
  v_perm_b32 v89, v203, v199, s45
  v_mfma_f32_16x16x32_bf16 v[116:119], v[56:59], v[84:87], 0
  s_nop 0
  v_mfma_f32_16x16x32_bf16 v[120:123], v[56:59], v[88:91], 0
  v_cvt_pk_bf16_f32 v172, v92, v96
  v_cvt_pk_bf16_f32 v176, v93, v97
  v_cvt_pk_bf16_f32 v180, v94, v98
  v_cvt_pk_bf16_f32 v184, v95, v99
  v_cvt_pk_bf16_f32 v173, v100, v104
  v_cvt_pk_bf16_f32 v177, v101, v105
  v_cvt_pk_bf16_f32 v181, v102, v106
  v_cvt_pk_bf16_f32 v185, v103, v107
  v_cvt_pk_bf16_f32 v174, v108, v112
  v_cvt_pk_bf16_f32 v178, v109, v113
  v_cvt_pk_bf16_f32 v182, v110, v114
  v_cvt_pk_bf16_f32 v186, v111, v115
  v_cvt_pk_bf16_f32 v175, v116, v120
  buffer_store_dwordx4 v[172:175], v5, s[24:27], s31 offen offset:0
  v_cvt_pk_bf16_f32 v179, v117, v121
  buffer_store_dwordx4 v[176:179], v5, s[24:27], s31 offen offset:1024
  v_cvt_pk_bf16_f32 v183, v118, v122
  buffer_store_dwordx4 v[180:183], v5, s[24:27], s31 offen offset:2048
  v_cvt_pk_bf16_f32 v187, v119, v123
  buffer_store_dwordx4 v[184:187], v5, s[24:27], s31 offen offset:3072
L_end:
  s_endpgm
.section .rodata,"a"
.p2align 6
.amdhsa_kernel standalone__sliding_local_strided__prompt_kernel
  .amdhsa_next_free_vgpr 300
  .amdhsa_next_free_sgpr 56
  .amdhsa_accum_offset 252
  .amdhsa_group_segment_fixed_size 0
  .amdhsa_kernarg_size 48
  .amdhsa_user_sgpr_count 2
  .amdhsa_user_sgpr_kernarg_segment_ptr 1
  .amdhsa_system_sgpr_workgroup_id_x 1
  .amdhsa_float_denorm_mode_32 3
.end_amdhsa_kernel
```
